```python
import torch

def _softmax(x, axis=-1):
    return torch.softmax(x, dim=axis)
def _gelu(x):
    return torch.nn.functional.gelu(x, approximate="tanh")
def _silu(x):
    return torch.nn.functional.silu(x)
def _sigmoid(x):
    return torch.sigmoid(x)
def _layernorm(x, axis=-1, eps=1e-5):
    m = x.mean(dim=axis, keepdim=True)
    v = x.var(dim=axis, keepdim=True, unbiased=False)
    return (x - m) / torch.sqrt(v + eps)
def _scatter_add(tgt, idx, src, axis=0):
    return tgt.clone().index_add_(axis, idx, src)
def _segment_sum(src, seg, n):
    out = torch.zeros((n,) + src.shape[1:], dtype=src.dtype)
    return out.index_add_(0, seg, src)
def _pad(x, pw):
    flat = tuple(v for pair in reversed(pw) for v in pair)
    return torch.nn.functional.pad(x, flat)

kernel_name = 'standalone__spectral_conv_chebnet__graph'

def setup_inputs():

    _w = (lambda a: (lambda t: t.to(torch.bfloat16) if t.is_floating_point() else t)(torch.as_tensor(a)))
    N, deg, D, K = 50000, 16, 64, 3
    E = N * deg
    src = (lambda lo, hi, *s: torch.randint(lo, hi, s))(0, N, E).to(torch.int64)
    dst = (lambda lo, hi, *s: torch.randint(lo, hi, s))(0, N, E).to(torch.int64)
    deg_cnt = torch.bincount(dst, minlength=N).to(float) + 1.0
    dis = (1.0 / (lambda _x: torch.sqrt(torch.as_tensor(_x)))(deg_cnt)).to(float)
    ew = -(dis[src] * dis[dst])
    return {
        "x": _w((lambda *s: torch.randn(*s, dtype=torch.bfloat16) * 0.05)(N, D)),
        "src": _w(src),
        "dst": _w(dst),
        "ew": _w(ew),
        "w": _w((lambda *s: torch.randn(*s, dtype=torch.bfloat16) * 0.05)(K, D, D) * 0.2),
    }

def reference(x, src, dst, ew, w):
    N, K = x.shape[0], w.shape[0]
    Ts = [x]
    if K > 1:
        Ts.append(_segment_sum(ew[:, None] * x[src], dst, N))
    for k in range(2, K):
        Tk = 2.0 * _segment_sum(ew[:, None] * Ts[-1][src], dst, N) - Ts[-2]
        Ts.append(Tk)
    T = torch.stack(Ts, 0)
    return torch.einsum('knd,kde->ne', T, w)
```

```asm
; @launch grid=(256,1,1) block=(1024,1,1) lds=162048
.amdgcn_target "amdgcn-amd-amdhsa--gfx950"
    .text
    .globl standalone__spectral_conv_chebnet__graph_kernel
    .p2align 8
    .type standalone__spectral_conv_chebnet__graph_kernel,@function
standalone__spectral_conv_chebnet__graph_kernel:
    s_cmp_ge_u32 s2, 256
    s_cbranch_scc1 K_END
    s_load_dwordx2 s[4:5], s[0:1], 0
    s_load_dwordx2 s[6:7], s[0:1], 56
    s_load_dwordx4 s[8:11], s[0:1], 40
    v_and_b32 v1, 63, v0
    v_lshrrev_b32 v73, 6, v0
    v_lshlrev_b32 v72, 4, v1
    v_readfirstlane_b32 s31, v73
    v_mov_b32 v126, 1
    v_mov_b32 v127, 0
    s_load_dwordx4 s[52:55], s[0:1], 8
    s_load_dwordx4 s[56:59], s[0:1], 24
    s_mul_i32 s3, s2, 12800
    v_lshlrev_b32 v2, 4, v0
    v_add_u32 v2, s3, v2
    v_lshrrev_b32 v3, 1, v2
    v_and_b32 v24, 0xff, v0
    v_lshlrev_b32 v24, 2, v24
    ds_write_b32 v24, v127
    s_waitcnt lgkmcnt(0)
    s_cmp_ge_u32 s2, 250
    s_cbranch_scc1 P_WPREP
    s_mov_b32 s40, s54
    s_and_b32 s41, s55, 0xffff
    s_mov_b32 s42, 3200000
    s_mov_b32 s43, 0x00020000
    v_cmp_gt_u32 vcc, 800, v0
    s_and_saveexec_b64 s[64:65], vcc
    s_mov_b64 s[62:63], exec
    s_cbranch_execz P_SKIP1
    buffer_load_dwordx4 v[4:7], v2, s[40:43], 0 offen
P_SKIP1:
    s_mov_b64 exec, -1
    s_mov_b32 s36, s52
    s_and_b32 s37, s53, 0xffff
    s_mov_b32 s38, 3200000
    s_mov_b32 s39, 0x00020000
    s_mov_b32 s44, s56
    s_and_b32 s45, s57, 0xffff
    s_mov_b32 s46, 1600000
    s_mov_b32 s47, 0x00020000
    s_barrier
    s_mov_b64 exec, s[62:63]
    s_cbranch_execz P_SKIP2
    buffer_load_dwordx4 v[8:11], v2, s[36:39], 0 offen
    buffer_load_dwordx2 v[12:13], v3, s[44:47], 0 offen
    s_waitcnt vmcnt(2)
    v_lshrrev_b32 v14, 2, v4
    v_mul_u32_u24 v14, 21400, v14
    v_lshrrev_b32 v14, 20, v14
    v_lshlrev_b32 v14, 2, v14
    ds_add_rtn_u32 v18, v14, v126
    v_lshrrev_b32 v15, 2, v5
    v_mul_u32_u24 v15, 21400, v15
    v_lshrrev_b32 v15, 20, v15
    v_lshlrev_b32 v15, 2, v15
    ds_add_rtn_u32 v19, v15, v126
    v_lshrrev_b32 v16, 2, v6
    v_mul_u32_u24 v16, 21400, v16
    v_lshrrev_b32 v16, 20, v16
    v_lshlrev_b32 v16, 2, v16
    ds_add_rtn_u32 v20, v16, v126
    v_lshrrev_b32 v17, 2, v7
    v_mul_u32_u24 v17, 21400, v17
    v_lshrrev_b32 v17, 20, v17
    v_lshlrev_b32 v17, 2, v17
    ds_add_rtn_u32 v21, v17, v126
P_SKIP2:
    s_mov_b64 exec, -1
    s_mov_b32 s16, s6
    s_and_b32 s17, s7, 0xffff
    s_mov_b32 s18, 14745600
    s_mov_b32 s19, 0x00020000
    s_mov_b32 s60, 0xffff0000
    s_waitcnt lgkmcnt(0)
    s_barrier
    s_cmp_eq_u32 s31, 15
    s_cbranch_scc0 P_SKIP3
    ds_read_b128 v[32:35], v72
    s_waitcnt lgkmcnt(0)
    v_add_u32 v36, v32, v33
    v_add_u32 v37, v36, v34
    v_add_u32 v38, v37, v35
    v_mov_b32 v39, v38
    s_nop 1
    v_add_u32_dpp v39, v39, v39 row_shr:1 row_mask:0xf bank_mask:0xf bound_ctrl:0
    s_nop 1
    v_add_u32_dpp v39, v39, v39 row_shr:2 row_mask:0xf bank_mask:0xf bound_ctrl:0
    s_nop 1
    v_add_u32_dpp v39, v39, v39 row_shr:4 row_mask:0xf bank_mask:0xf bound_ctrl:0
    s_nop 1
    v_add_u32_dpp v39, v39, v39 row_shr:8 row_mask:0xf bank_mask:0xf bound_ctrl:0
    s_nop 1
    v_add_u32_dpp v39, v39, v39 row_bcast:15 row_mask:0xa bank_mask:0xf
    s_nop 1
    v_add_u32_dpp v39, v39, v39 row_bcast:31 row_mask:0xc bank_mask:0xf
    s_nop 1
    v_sub_u32 v40, v39, v38
    v_add_u32 v41, v40, v32
    v_add_u32 v42, v40, v36
    v_add_u32 v43, v40, v37
    v_add_u32 v48, 128, v40
    v_add_u32 v49, 128, v41
    v_add_u32 v50, 128, v42
    v_add_u32 v51, 128, v43
    ds_write_b128 v72, v[48:51]
    v_lshl_or_b32 v44, v32, 16, v40
    v_lshl_or_b32 v45, v33, 16, v41
    v_lshl_or_b32 v46, v34, 16, v42
    v_lshl_or_b32 v47, v35, 16, v43
    s_lshl_b32 s52, s2, 10
    s_add_u32 s52, s52, 6815744
    buffer_store_dwordx4 v[44:47], v72, s[16:19], s52 offen sc1
P_SKIP3:
    s_waitcnt lgkmcnt(0)
    s_barrier
    s_mov_b64 exec, s[62:63]
    s_cbranch_execz P_SKIP4
    ds_read_b32 v14, v14
    ds_read_b32 v15, v15
    ds_read_b32 v16, v16
    ds_read_b32 v17, v17
    s_waitcnt vmcnt(0)
    v_lshl_or_b32 v8, v12, 16, v8
    v_and_or_b32 v9, v12, s60, v9
    v_lshl_or_b32 v10, v13, 16, v10
    v_and_or_b32 v11, v13, s60, v11
    s_waitcnt lgkmcnt(3)
    v_add_lshl_u32 v14, v14, v18, 3
    s_waitcnt lgkmcnt(2)
    v_add_lshl_u32 v15, v15, v19, 3
    s_waitcnt lgkmcnt(1)
    v_add_lshl_u32 v16, v16, v20, 3
    s_waitcnt lgkmcnt(0)
    v_add_lshl_u32 v17, v17, v21, 3
    ds_write2_b32 v14, v8, v4 offset0:0 offset1:1
    ds_write2_b32 v15, v9, v5 offset0:0 offset1:1
    ds_write2_b32 v16, v10, v6 offset0:0 offset1:1
    ds_write2_b32 v17, v11, v7 offset0:0 offset1:1
P_SKIP4:
    s_mov_b64 exec, -1
    s_waitcnt lgkmcnt(0)
    s_barrier
    v_lshlrev_b32 v30, 4, v0
    ds_read_b128 v[32:35], v30 offset:1024
    s_mul_i32 s52, s2, 25600
    s_add_u32 s53, s52, 0x4000
    s_cmp_ge_u32 s31, 9
    s_cbranch_scc1 P_SKIP5
    ds_read_b128 v[36:39], v30 offset:17408
    s_waitcnt lgkmcnt(0)
    buffer_store_dwordx4 v[36:39], v30, s[16:19], s53 offen sc1
P_SKIP5:
    s_waitcnt lgkmcnt(0)
    buffer_store_dwordx4 v[32:35], v30, s[16:19], s52 offen sc1
    s_branch P_END
P_WPREP:
    s_mov_b32 s16, s6
    s_and_b32 s17, s7, 0xffff
    s_mov_b32 s18, 14745600
    s_mov_b32 s19, 0x00020000
    s_mov_b32 s48, s58
    s_and_b32 s49, s59, 0xffff
    s_mov_b32 s50, 24576
    s_mov_b32 s51, 0x00020000
    s_sub_u32 s52, s2, 250
    s_lshl_b32 s52, s52, 2
    s_lshr_b32 s53, s31, 2
    s_add_u32 s52, s52, s53
    v_and_b32 v30, 0xff, v0
    s_lshr_b32 s54, s52, 3
    s_bfe_u32 s55, s52, 0x10002
    s_and_b32 s56, s52, 3
    v_and_b32 v31, 3, v30
    v_bfe_u32 v32, v30, 2, 4
    v_lshrrev_b32 v33, 6, v30
    v_lshrrev_b32 v34, 2, v32
    v_lshlrev_b32 v34, 4, v34
    v_and_b32 v35, 3, v32
    v_add_u32 v34, v34, v35
    s_lshl_b32 s57, s56, 2
    v_add_u32 v34, s57, v34
    v_lshlrev_b32 v36, 4, v33
    v_lshl_add_u32 v36, v31, 1, v36
    s_lshl_b32 s57, s55, 3
    v_add_u32 v36, s57, v36
    v_lshrrev_b32 v37, 1, v31
    v_lshlrev_b32 v37, 4, v37
    v_lshl_add_u32 v37, v33, 2, v37
    v_and_b32 v35, 1, v31
    v_lshl_add_u32 v37, v35, 1, v37
    s_lshl_b32 s57, s55, 5
    v_add_u32 v37, s57, v37
    s_cmp_eq_u32 s54, 1
    s_cselect_b64 vcc, -1, 0
    s_nop 1
    v_cndmask_b32 v36, v36, v37, vcc
    v_lshlrev_b32 v36, 7, v36
    v_lshl_add_u32 v36, v34, 1, v36
    s_lshl_b32 s57, s54, 13
    v_add_u32 v36, s57, v36
    buffer_load_ushort v37, v36, s[48:51], 0 offen
    buffer_load_ushort v38, v36, s[48:51], 0 offen offset:128
    s_lshl_b32 s57, s52, 10
    s_add_u32 s57, s57, 14680064
    v_lshlrev_b32 v39, 2, v30
    v_add_u32 v39, s57, v39
    s_waitcnt vmcnt(0)
    v_lshl_or_b32 v37, v38, 16, v37
    buffer_store_dword v37, v39, s[16:19], 0 offen sc1
P_END:
    s_mov_b32 s20, s4
    s_and_b32 s21, s5, 0xffff
    s_mov_b32 s22, 6400000
    s_mov_b32 s23, 0x00020000
    s_and_b32 s28, s2, 7
    s_lshl_b32 s69, s28, 17
    s_mov_b32 s69, 0
    s_lshl_b32 s28, s28, 5
    s_lshr_b32 s42, s2, 3
    s_add_u32 s28, s28, s42
    s_mul_i32 s29, s28, 196
    s_sub_u32 s42, 50000, s29
    s_min_u32 s42, s42, 196
    s_add_u32 s30, s42, 15
    s_lshr_b32 s30, s30, 4
    s_lshl_b32 s43, s31, 4
    s_sub_i32 s74, s42, s43
    s_min_i32 s74, s74, 16
    s_lshl_b32 s74, s74, 7
    s_add_u32 s75, s29, s43
    s_lshl_b32 s75, s75, 7
    v_mov_b32 v3, 4
    s_movk_i32 s32, 128
    s_mov_b32 s33, 0x000f000f
    s_mov_b32 s68, 0x07060302
    s_min_u32 s42, s31, 12
    s_lshl_b32 s34, s42, 13
    s_add_u32 s34, s34, 55552
    s_mul_i32 s35, s42, 1536
    s_add_u32 s35, s35, 1024
    s_mov_b32 s70, 1
    s_movk_i32 s79, 4026
    s_mov_b32 s12, s4
    s_and_b32 s13, s5, 0xffff
    s_mov_b32 s14, 6400000
    s_mov_b32 s15, 0x00020000
    s_mov_b32 s24, s8
    s_and_b32 s25, s9, 0xffff
    s_mov_b32 s26, 6400000
    s_mov_b32 s27, 0x00020000
    v_and_b32 v73, 8, v1
    v_lshlrev_b32 v73, 2, v73
    v_and_b32 v74, 16, v1
    v_or_b32 v73, v73, v74
    v_and_b32 v74, 32, v1
    v_lshl_or_b32 v73, v74, 1, v73
    v_add_u32 v68, s35, v73
    v_and_b32 v73, 48, v1
    v_lshl_add_u32 v69, v73, 1, s35
    s_sub_u32 s42, s35, 1024
    s_lshr_b32 s42, s42, 1
    s_add_u32 s42, s42, 20992
    v_add_u32 v70, s42, v73
    v_and_b32 v73, 7, v1
    v_xor_b32 v60, 0, v73
    v_lshlrev_b32 v60, 4, v60
    v_xor_b32 v61, 2, v73
    v_lshlrev_b32 v61, 4, v61
    v_xor_b32 v62, 4, v73
    v_lshlrev_b32 v62, 4, v62
    v_xor_b32 v63, 6, v73
    v_lshlrev_b32 v63, 4, v63
    v_bfe_u32 v73, v1, 2, 2
    v_lshlrev_b32 v74, 10, v73
    v_and_b32 v75, 16, v1
    v_lshl_add_u32 v74, v75, 3, v74
    v_and_b32 v75, 32, v1
    v_lshl_add_u32 v74, v75, 4, v74
    v_and_b32 v75, 3, v1
    v_lshl_add_u32 v74, v75, 3, v74
    v_add_u32 v74, s34, v74
    v_xor_b32 v75, 0, v73
    v_lshl_add_u32 v64, v75, 5, v74
    v_xor_b32 v75, 1, v73
    v_lshl_add_u32 v65, v75, 5, v74
    v_xor_b32 v75, 2, v73
    v_lshl_add_u32 v66, v75, 5, v74
    v_xor_b32 v75, 3, v73
    v_lshl_add_u32 v67, v75, 5, v74
    v_and_b32 v73, 15, v1
    v_sub_u32 v73, 15, v73
    v_lshl_or_b32 v71, v73, 16, v73
    v_mov_b32 v4, 0
    v_mov_b32 v5, 0
    v_mov_b32 v6, 0
    v_mov_b32 v7, 0
    v_mov_b32 v8, 0
    v_mov_b32 v9, 0
    v_mov_b32 v10, 0
    v_mov_b32 v11, 0
    v_mov_b32 v12, 0
    v_mov_b32 v13, 0
    v_mov_b32 v14, 0
    v_mov_b32 v15, 0
    v_mov_b32 v16, 0
    v_mov_b32 v17, 0
    v_mov_b32 v18, 0
    v_mov_b32 v19, 0
    v_lshrrev_b32 v73, 4, v0
    v_and_b32 v124, 15, v0
    v_mul_u32_u24 v125, 102400, v73
    v_lshl_add_u32 v125, v124, 3, v125
    s_lshl_b32 s42, s28, 2
    s_add_u32 s42, s42, 6815744
    v_lshlrev_b32 v100, 12, v73
    v_add_u32 v100, s42, v100
    v_mov_b32 v74, 0x7f000000
    v_lshlrev_b32 v73, 2, v73
    v_cmp_gt_u32 vcc, 248, v73
    s_nop 1
    v_cndmask_b32 v82, v74, v100, vcc
    v_cmp_gt_u32 vcc, 250, v73
    s_nop 1
    v_cndmask_b32 v80, v74, v100, vcc
    s_waitcnt vmcnt(0) lgkmcnt(0)
    s_barrier
    s_cmp_eq_u32 s31, 15
    s_cbranch_scc1 GB0_POLL
    s_cmp_eq_u32 s31, 0
    s_cbranch_scc0 B1_END
    v_lshlrev_b32 v73, 2, v1
    ds_write_b32 v73, v127 offset:0
    s_waitcnt lgkmcnt(0)
B1_END:
    s_branch GB0_JOIN
GB0_POLL:
    s_mov_b64 exec, 1
    s_and_b32 s42, s2, 1
    s_lshl_b32 s42, s42, 6
    s_add_u32 s42, s42, 0
    v_mov_b32 v73, s42
    v_mov_b32 v74, 128
    global_atomic_add v75, v73, v126, s[10:11] sc0 sc1
    s_waitcnt vmcnt(0)
    v_readfirstlane_b32 s42, v75
    s_cmp_eq_u32 s42, 127
    s_cbranch_scc0 GB0_SPIN0
    global_atomic_add v74, v126, s[10:11] sc1
GB0_SPIN0:
    s_mov_b32 s71, 0
GB0_SPIN:
    global_load_dword v75, v74, s[10:11] sc1
    s_waitcnt vmcnt(0)
    v_readfirstlane_b32 s42, v75
    s_cmp_ge_u32 s42, 2
    s_cbranch_scc1 GB0_DONE
    s_add_u32 s71, s71, 1
    s_cmp_ge_u32 s71, 0x400000
    s_cbranch_scc1 GB0_DONE
    s_sleep 2
    s_branch GB0_SPIN
GB0_DONE:
    s_mov_b64 exec, -1
GB0_JOIN:
    s_barrier
    v_mov_b32 v73, v80
    v_mov_b32 v74, v82
    buffer_load_dword v80, v73, s[16:19], 0 offen
    buffer_load_dword v81, v73, s[16:19], 0 offen offset:1024
    buffer_load_dword v82, v74, s[16:19], 0 offen offset:2048
    buffer_load_dword v83, v74, s[16:19], 0 offen offset:3072
    s_mov_b32 s36, 0
FS_WIN:
    s_lshl_b32 s43, s36, 3
    v_add_u32 v76, 16, v124
    v_mov_b32 v77, 0x7f000000
    v_mov_b32 v79, 0
    s_waitcnt vmcnt(3)
    v_lshrrev_b32 v73, 16, v80
    v_subrev_u32 v73, s36, v73
    v_max_i32 v79, v79, v73
    v_cmp_gt_i32 s[48:49], v73, v124
    v_cmp_gt_i32 s[50:51], v73, v76
    v_and_b32 v74, 0xffff, v80
    v_lshl_add_u32 v74, v74, 3, v125
    s_add_u32 s42, s43, 0
    v_cndmask_b32 v75, v77, v74, s[48:49]
    v_cndmask_b32 v78, v77, v74, s[50:51]
    buffer_load_dwordx2 v[84:85], v75, s[16:19], s42 offen
    buffer_load_dwordx2 v[86:87], v78, s[16:19], s42 offen offset:128
    s_waitcnt vmcnt(4)
    v_lshrrev_b32 v73, 16, v81
    v_subrev_u32 v73, s36, v73
    v_max_i32 v79, v79, v73
    v_cmp_gt_i32 s[52:53], v73, v124
    v_cmp_gt_i32 s[54:55], v73, v76
    v_and_b32 v74, 0xffff, v81
    v_lshl_add_u32 v74, v74, 3, v125
    s_add_u32 s42, s43, 25600
    v_cndmask_b32 v75, v77, v74, s[52:53]
    v_cndmask_b32 v78, v77, v74, s[54:55]
    buffer_load_dwordx2 v[88:89], v75, s[16:19], s42 offen
    buffer_load_dwordx2 v[90:91], v78, s[16:19], s42 offen offset:128
    s_waitcnt vmcnt(5)
    v_lshrrev_b32 v73, 16, v82
    v_subrev_u32 v73, s36, v73
    v_max_i32 v79, v79, v73
    v_cmp_gt_i32 s[56:57], v73, v124
    v_cmp_gt_i32 s[58:59], v73, v76
    v_and_b32 v74, 0xffff, v82
    v_lshl_add_u32 v74, v74, 3, v125
    s_add_u32 s42, s43, 51200
    v_cndmask_b32 v75, v77, v74, s[56:57]
    v_cndmask_b32 v78, v77, v74, s[58:59]
    buffer_load_dwordx2 v[92:93], v75, s[16:19], s42 offen
    buffer_load_dwordx2 v[94:95], v78, s[16:19], s42 offen offset:128
    s_waitcnt vmcnt(6)
    v_lshrrev_b32 v73, 16, v83
    v_subrev_u32 v73, s36, v73
    v_max_i32 v79, v79, v73
    v_cmp_gt_i32 s[60:61], v73, v124
    v_cmp_gt_i32 s[62:63], v73, v76
    v_and_b32 v74, 0xffff, v83
    v_lshl_add_u32 v74, v74, 3, v125
    s_add_u32 s42, s43, 76800
    v_cndmask_b32 v75, v77, v74, s[60:61]
    v_cndmask_b32 v78, v77, v74, s[62:63]
    buffer_load_dwordx2 v[96:97], v75, s[16:19], s42 offen
    buffer_load_dwordx2 v[98:99], v78, s[16:19], s42 offen offset:128
    s_movk_i32 s44, 1536
    s_waitcnt vmcnt(7)
    s_mov_b64 exec, s[48:49]
    v_subrev_u32 v85, s29, v85
    v_mad_u32_u16 v73, v84, s79, 0
    v_lshrrev_b32 v74, 4, v85
    v_lshrrev_b32 v73, 26, v73
    v_lshl_add_u32 v75, v74, 2, v73
    v_lshlrev_b32 v75, 2, v75
    ds_add_rtn_u32 v100, v75, v3
    v_mul_u32_u24 v74, s44, v74
    v_lshl_add_u32 v20, v73, 9, v74
    v_and_b32 v85, 15, v85
    v_lshlrev_b32 v85, v85, v126
    s_waitcnt vmcnt(6)
    s_mov_b64 exec, s[50:51]
    s_cbranch_execz FS_RK1
    v_subrev_u32 v87, s29, v87
    v_mad_u32_u16 v73, v86, s79, 0
    v_lshrrev_b32 v74, 4, v87
    v_lshrrev_b32 v73, 26, v73
    v_lshl_add_u32 v75, v74, 2, v73
    v_lshlrev_b32 v75, 2, v75
    ds_add_rtn_u32 v101, v75, v3
    v_mul_u32_u24 v74, s44, v74
    v_lshl_add_u32 v21, v73, 9, v74
    v_and_b32 v87, 15, v87
    v_lshlrev_b32 v87, v87, v126
FS_RK1:
    s_waitcnt vmcnt(5)
    s_mov_b64 exec, s[52:53]
    v_subrev_u32 v89, s29, v89
    v_mad_u32_u16 v73, v88, s79, 0
    v_lshrrev_b32 v74, 4, v89
    v_lshrrev_b32 v73, 26, v73
    v_lshl_add_u32 v75, v74, 2, v73
    v_lshlrev_b32 v75, 2, v75
    ds_add_rtn_u32 v102, v75, v3
    v_mul_u32_u24 v74, s44, v74
    v_lshl_add_u32 v22, v73, 9, v74
    v_and_b32 v89, 15, v89
    v_lshlrev_b32 v89, v89, v126
    s_waitcnt vmcnt(4)
    s_mov_b64 exec, s[54:55]
    s_cbranch_execz FS_RK3
    v_subrev_u32 v91, s29, v91
    v_mad_u32_u16 v73, v90, s79, 0
    v_lshrrev_b32 v74, 4, v91
    v_lshrrev_b32 v73, 26, v73
    v_lshl_add_u32 v75, v74, 2, v73
    v_lshlrev_b32 v75, 2, v75
    ds_add_rtn_u32 v103, v75, v3
    v_mul_u32_u24 v74, s44, v74
    v_lshl_add_u32 v23, v73, 9, v74
    v_and_b32 v91, 15, v91
    v_lshlrev_b32 v91, v91, v126
FS_RK3:
    s_waitcnt vmcnt(3)
    s_mov_b64 exec, s[56:57]
    v_subrev_u32 v93, s29, v93
    v_mad_u32_u16 v73, v92, s79, 0
    v_lshrrev_b32 v74, 4, v93
    v_lshrrev_b32 v73, 26, v73
    v_lshl_add_u32 v75, v74, 2, v73
    v_lshlrev_b32 v75, 2, v75
    ds_add_rtn_u32 v104, v75, v3
    v_mul_u32_u24 v74, s44, v74
    v_lshl_add_u32 v24, v73, 9, v74
    v_and_b32 v93, 15, v93
    v_lshlrev_b32 v93, v93, v126
    s_waitcnt vmcnt(2)
    s_mov_b64 exec, s[58:59]
    s_cbranch_execz FS_RK5
    v_subrev_u32 v95, s29, v95
    v_mad_u32_u16 v73, v94, s79, 0
    v_lshrrev_b32 v74, 4, v95
    v_lshrrev_b32 v73, 26, v73
    v_lshl_add_u32 v75, v74, 2, v73
    v_lshlrev_b32 v75, 2, v75
    ds_add_rtn_u32 v105, v75, v3
    v_mul_u32_u24 v74, s44, v74
    v_lshl_add_u32 v25, v73, 9, v74
    v_and_b32 v95, 15, v95
    v_lshlrev_b32 v95, v95, v126
FS_RK5:
    s_waitcnt vmcnt(1)
    s_mov_b64 exec, s[60:61]
    v_subrev_u32 v97, s29, v97
    v_mad_u32_u16 v73, v96, s79, 0
    v_lshrrev_b32 v74, 4, v97
    v_lshrrev_b32 v73, 26, v73
    v_lshl_add_u32 v75, v74, 2, v73
    v_lshlrev_b32 v75, 2, v75
    ds_add_rtn_u32 v106, v75, v3
    v_mul_u32_u24 v74, s44, v74
    v_lshl_add_u32 v26, v73, 9, v74
    v_and_b32 v97, 15, v97
    v_lshlrev_b32 v97, v97, v126
    s_waitcnt vmcnt(0)
    s_mov_b64 exec, s[62:63]
    s_cbranch_execz FS_RK7
    v_subrev_u32 v99, s29, v99
    v_mad_u32_u16 v73, v98, s79, 0
    v_lshrrev_b32 v74, 4, v99
    v_lshrrev_b32 v73, 26, v73
    v_lshl_add_u32 v75, v74, 2, v73
    v_lshlrev_b32 v75, 2, v75
    ds_add_rtn_u32 v107, v75, v3
    v_mul_u32_u24 v74, s44, v74
    v_lshl_add_u32 v27, v73, 9, v74
    v_and_b32 v99, 15, v99
    v_lshlrev_b32 v99, v99, v126
FS_RK7:
    s_waitcnt lgkmcnt(0)
    s_movk_i32 s44, 508
    s_mov_b64 exec, s[48:49]
    v_min_u32 v100, s44, v100
    v_add_u32 v100, v100, v20
    v_lshrrev_b32 v20, 1, v100
    ds_write_b32 v100, v84 offset:1024
    ds_write_b16 v20, v85 offset:20992
    s_mov_b64 exec, s[50:51]
    s_cbranch_execz FS_WR1
    v_min_u32 v101, s44, v101
    v_add_u32 v101, v101, v21
    v_lshrrev_b32 v21, 1, v101
    ds_write_b32 v101, v86 offset:1024
    ds_write_b16 v21, v87 offset:20992
FS_WR1:
    s_mov_b64 exec, s[52:53]
    v_min_u32 v102, s44, v102
    v_add_u32 v102, v102, v22
    v_lshrrev_b32 v22, 1, v102
    ds_write_b32 v102, v88 offset:1024
    ds_write_b16 v22, v89 offset:20992
    s_mov_b64 exec, s[54:55]
    s_cbranch_execz FS_WR3
    v_min_u32 v103, s44, v103
    v_add_u32 v103, v103, v23
    v_lshrrev_b32 v23, 1, v103
    ds_write_b32 v103, v90 offset:1024
    ds_write_b16 v23, v91 offset:20992
FS_WR3:
    s_mov_b64 exec, s[56:57]
    v_min_u32 v104, s44, v104
    v_add_u32 v104, v104, v24
    v_lshrrev_b32 v24, 1, v104
    ds_write_b32 v104, v92 offset:1024
    ds_write_b16 v24, v93 offset:20992
    s_mov_b64 exec, s[58:59]
    s_cbranch_execz FS_WR5
    v_min_u32 v105, s44, v105
    v_add_u32 v105, v105, v25
    v_lshrrev_b32 v25, 1, v105
    ds_write_b32 v105, v94 offset:1024
    ds_write_b16 v25, v95 offset:20992
FS_WR5:
    s_mov_b64 exec, s[60:61]
    v_min_u32 v106, s44, v106
    v_add_u32 v106, v106, v26
    v_lshrrev_b32 v26, 1, v106
    ds_write_b32 v106, v96 offset:1024
    ds_write_b16 v26, v97 offset:20992
    s_mov_b64 exec, s[62:63]
    s_cbranch_execz FS_WR7
    v_min_u32 v107, s44, v107
    v_add_u32 v107, v107, v27
    v_lshrrev_b32 v27, 1, v107
    ds_write_b32 v107, v98 offset:1024
    ds_write_b16 v27, v99 offset:20992
FS_WR7:
    s_mov_b64 exec, -1
    v_cmp_lt_i32 vcc, 32, v79
    s_add_u32 s36, s36, 32
    s_cbranch_vccnz FS_WIN
    s_cmp_ge_u32 s31, 13
    s_cbranch_scc1 XW_W
    v_and_b32 v73, 15, v1
    v_lshlrev_b32 v73, 7, v73
    v_and_b32 v74, 48, v1
    v_lshl_add_u32 v73, v74, 1, v73
    buffer_load_dwordx4 v[108:111], v73, s[20:23], s75 offen
    buffer_load_dwordx4 v[112:115], v73, s[20:23], s75 offen offset:16
    s_branch XW_END
XW_W:
    s_sub_u32 s42, s31, 13
    s_lshl_b32 s42, s42, 13
    s_add_u32 m0, s42, 30976
    s_add_u32 s43, s42, 14680064
    buffer_load_dwordx4 v72, s[16:19], s43 offen offset:0 lds
    buffer_load_dwordx4 v72, s[16:19], s43 offen offset:1024 lds
    buffer_load_dwordx4 v72, s[16:19], s43 offen offset:2048 lds
    buffer_load_dwordx4 v72, s[16:19], s43 offen offset:3072 lds
    s_add_u32 m0, s42, 35072
    s_add_u32 s43, s42, 14684160
    buffer_load_dwordx4 v72, s[16:19], s43 offen offset:0 lds
    buffer_load_dwordx4 v72, s[16:19], s43 offen offset:1024 lds
    buffer_load_dwordx4 v72, s[16:19], s43 offen offset:2048 lds
    buffer_load_dwordx4 v72, s[16:19], s43 offen offset:3072 lds
XW_END:
    v_lshlrev_b32 v73, 2, v1
    s_waitcnt lgkmcnt(0)
    s_barrier
    ds_read_b32 v77, v73 offset:0
    s_lshl_b32 s45, s31, 2
    s_sub_u32 s46, s35, 1024
    s_mov_b32 s72, 0
    v_mov_b32 v76, 0xffff
    s_waitcnt lgkmcnt(0)
    v_cmp_lt_u32 vcc, 0x200, v77
    s_mov_b32 s73, 0
    s_cbranch_vccnz A_START0
    s_mov_b32 s73, 1
    s_cmp_ge_u32 s31, 13
    s_cbranch_scc1 FS_END
    s_add_u32 s42, s45, 0
    s_nop 0
    v_readlane_b32 s42, v77, s42
    s_nop 0
    s_add_u32 s43, s42, 127
    s_lshr_b32 s43, s43, 7
    s_bfm_b32 s44, s43, 0
    s_or_b32 s72, s72, s44
    s_lshl_b32 s43, s43, 7
    v_add_u32 v74, s42, v73
    v_cmp_gt_u32 vcc, s43, v74
    v_add_u32 v74, s46, v74
    v_lshrrev_b32 v75, 1, v74
    s_mov_b64 exec, vcc
    ds_write_b32 v74, v76 offset:1024
    ds_write_b16 v75, v127 offset:20992
    s_mov_b64 exec, -1
    s_add_u32 s42, s45, 1
    s_nop 0
    v_readlane_b32 s42, v77, s42
    s_nop 0
    s_add_u32 s43, s42, 127
    s_lshr_b32 s43, s43, 7
    s_bfm_b32 s44, s43, 4
    s_or_b32 s72, s72, s44
    s_lshl_b32 s43, s43, 7
    v_add_u32 v74, s42, v73
    v_cmp_gt_u32 vcc, s43, v74
    v_add_u32 v74, s46, v74
    v_lshrrev_b32 v75, 1, v74
    s_mov_b64 exec, vcc
    ds_write_b32 v74, v76 offset:1536
    ds_write_b16 v75, v127 offset:21248
    s_mov_b64 exec, -1
    s_add_u32 s42, s45, 2
    s_nop 0
    v_readlane_b32 s42, v77, s42
    s_nop 0
    s_add_u32 s43, s42, 127
    s_lshr_b32 s43, s43, 7
    s_bfm_b32 s44, s43, 8
    s_or_b32 s72, s72, s44
    s_lshl_b32 s43, s43, 7
    v_add_u32 v74, s42, v73
    v_cmp_gt_u32 vcc, s43, v74
    v_add_u32 v74, s46, v74
    v_lshrrev_b32 v75, 1, v74
    s_mov_b64 exec, vcc
    ds_write_b32 v74, v76 offset:2048
    ds_write_b16 v75, v127 offset:21504
    s_mov_b64 exec, -1
FS_END:
    s_mov_b32 s67, s72
    s_mov_b32 s37, 0
    s_mov_b32 s40, 0
    s_mov_b32 s41, 0
    s_branch A_ML
A_START0:
    s_barrier
A_START:
    s_mov_b32 s36, 0
    s_mov_b32 s66, 0
A_WIN:
    v_lshlrev_b32 v73, 2, v0
    v_cmp_gt_u32 vcc, 130, v0
    s_and_saveexec_b64 s[64:65], vcc
    ds_write_b32 v73, v127
    s_mov_b64 exec, s[64:65]
    s_lshl_b32 s43, s36, 3
    v_add_u32 v76, 16, v124
    v_mov_b32 v77, 0x7f000000
    v_mov_b32 v79, 0
    s_waitcnt vmcnt(3)
    v_lshrrev_b32 v73, 16, v80
    v_subrev_u32 v73, s36, v73
    v_max_i32 v79, v79, v73
    v_cmp_gt_i32 s[48:49], v73, v124
    v_cmp_gt_i32 s[50:51], v73, v76
    v_and_b32 v74, 0xffff, v80
    v_lshl_add_u32 v74, v74, 3, v125
    s_add_u32 s42, s43, 0
    v_cndmask_b32 v75, v77, v74, s[48:49]
    v_cndmask_b32 v78, v77, v74, s[50:51]
    buffer_load_dwordx2 v[84:85], v75, s[16:19], s42 offen
    buffer_load_dwordx2 v[86:87], v78, s[16:19], s42 offen offset:128
    s_waitcnt vmcnt(4)
    v_lshrrev_b32 v73, 16, v81
    v_subrev_u32 v73, s36, v73
    v_max_i32 v79, v79, v73
    v_cmp_gt_i32 s[52:53], v73, v124
    v_cmp_gt_i32 s[54:55], v73, v76
    v_and_b32 v74, 0xffff, v81
    v_lshl_add_u32 v74, v74, 3, v125
    s_add_u32 s42, s43, 25600
    v_cndmask_b32 v75, v77, v74, s[52:53]
    v_cndmask_b32 v78, v77, v74, s[54:55]
    buffer_load_dwordx2 v[88:89], v75, s[16:19], s42 offen
    buffer_load_dwordx2 v[90:91], v78, s[16:19], s42 offen offset:128
    s_waitcnt vmcnt(5)
    v_lshrrev_b32 v73, 16, v82
    v_subrev_u32 v73, s36, v73
    v_max_i32 v79, v79, v73
    v_cmp_gt_i32 s[56:57], v73, v124
    v_cmp_gt_i32 s[58:59], v73, v76
    v_and_b32 v74, 0xffff, v82
    v_lshl_add_u32 v74, v74, 3, v125
    s_add_u32 s42, s43, 51200
    v_cndmask_b32 v75, v77, v74, s[56:57]
    v_cndmask_b32 v78, v77, v74, s[58:59]
    buffer_load_dwordx2 v[92:93], v75, s[16:19], s42 offen
    buffer_load_dwordx2 v[94:95], v78, s[16:19], s42 offen offset:128
    s_waitcnt vmcnt(6)
    v_lshrrev_b32 v73, 16, v83
    v_subrev_u32 v73, s36, v73
    v_max_i32 v79, v79, v73
    v_cmp_gt_i32 s[60:61], v73, v124
    v_cmp_gt_i32 s[62:63], v73, v76
    v_and_b32 v74, 0xffff, v83
    v_lshl_add_u32 v74, v74, 3, v125
    s_add_u32 s42, s43, 76800
    v_cndmask_b32 v75, v77, v74, s[60:61]
    v_cndmask_b32 v78, v77, v74, s[62:63]
    buffer_load_dwordx2 v[96:97], v75, s[16:19], s42 offen
    buffer_load_dwordx2 v[98:99], v78, s[16:19], s42 offen offset:128
    s_waitcnt lgkmcnt(0)
    s_barrier
    v_cmp_lt_i32 vcc, 32, v79
    s_and_saveexec_b64 s[64:65], vcc
    v_mov_b32 v73, 516
    ds_write_b32 v73, v126
    s_mov_b64 exec, s[64:65]
    s_movk_i32 s44, 1536
    s_waitcnt vmcnt(7)
    s_mov_b64 exec, s[48:49]
    v_subrev_u32 v85, s29, v85
    v_mad_u32_u16 v73, v84, 21, s69
    v_lshrrev_b32 v74, 4, v85
    v_bfe_u32 v73, v73, 17, 3
    v_lshl_add_u32 v20, v74, 3, v73
    v_lshlrev_b32 v20, 2, v20
    ds_add_rtn_u32 v100, v20, v3
    v_and_b32 v73, 15, v85
    v_lshlrev_b32 v73, v73, v126
    v_mul_u32_u24 v74, s44, v74
    v_lshl_or_b32 v85, v73, 16, v74
    s_waitcnt vmcnt(6)
    s_mov_b64 exec, s[50:51]
    s_cbranch_execz A_RK1
    v_subrev_u32 v87, s29, v87
    v_mad_u32_u16 v73, v86, 21, s69
    v_lshrrev_b32 v74, 4, v87
    v_bfe_u32 v73, v73, 17, 3
    v_lshl_add_u32 v21, v74, 3, v73
    v_lshlrev_b32 v21, 2, v21
    ds_add_rtn_u32 v101, v21, v3
    v_and_b32 v73, 15, v87
    v_lshlrev_b32 v73, v73, v126
    v_mul_u32_u24 v74, s44, v74
    v_lshl_or_b32 v87, v73, 16, v74
A_RK1:
    s_waitcnt vmcnt(5)
    s_mov_b64 exec, s[52:53]
    v_subrev_u32 v89, s29, v89
    v_mad_u32_u16 v73, v88, 21, s69
    v_lshrrev_b32 v74, 4, v89
    v_bfe_u32 v73, v73, 17, 3
    v_lshl_add_u32 v22, v74, 3, v73
    v_lshlrev_b32 v22, 2, v22
    ds_add_rtn_u32 v102, v22, v3
    v_and_b32 v73, 15, v89
    v_lshlrev_b32 v73, v73, v126
    v_mul_u32_u24 v74, s44, v74
    v_lshl_or_b32 v89, v73, 16, v74
    s_waitcnt vmcnt(4)
    s_mov_b64 exec, s[54:55]
    s_cbranch_execz A_RK3
    v_subrev_u32 v91, s29, v91
    v_mad_u32_u16 v73, v90, 21, s69
    v_lshrrev_b32 v74, 4, v91
    v_bfe_u32 v73, v73, 17, 3
    v_lshl_add_u32 v23, v74, 3, v73
    v_lshlrev_b32 v23, 2, v23
    ds_add_rtn_u32 v103, v23, v3
    v_and_b32 v73, 15, v91
    v_lshlrev_b32 v73, v73, v126
    v_mul_u32_u24 v74, s44, v74
    v_lshl_or_b32 v91, v73, 16, v74
A_RK3:
    s_waitcnt vmcnt(3)
    s_mov_b64 exec, s[56:57]
    v_subrev_u32 v93, s29, v93
    v_mad_u32_u16 v73, v92, 21, s69
    v_lshrrev_b32 v74, 4, v93
    v_bfe_u32 v73, v73, 17, 3
    v_lshl_add_u32 v24, v74, 3, v73
    v_lshlrev_b32 v24, 2, v24
    ds_add_rtn_u32 v104, v24, v3
    v_and_b32 v73, 15, v93
    v_lshlrev_b32 v73, v73, v126
    v_mul_u32_u24 v74, s44, v74
    v_lshl_or_b32 v93, v73, 16, v74
    s_waitcnt vmcnt(2)
    s_mov_b64 exec, s[58:59]
    s_cbranch_execz A_RK5
    v_subrev_u32 v95, s29, v95
    v_mad_u32_u16 v73, v94, 21, s69
    v_lshrrev_b32 v74, 4, v95
    v_bfe_u32 v73, v73, 17, 3
    v_lshl_add_u32 v25, v74, 3, v73
    v_lshlrev_b32 v25, 2, v25
    ds_add_rtn_u32 v105, v25, v3
    v_and_b32 v73, 15, v95
    v_lshlrev_b32 v73, v73, v126
    v_mul_u32_u24 v74, s44, v74
    v_lshl_or_b32 v95, v73, 16, v74
A_RK5:
    s_waitcnt vmcnt(1)
    s_mov_b64 exec, s[60:61]
    v_subrev_u32 v97, s29, v97
    v_mad_u32_u16 v73, v96, 21, s69
    v_lshrrev_b32 v74, 4, v97
    v_bfe_u32 v73, v73, 17, 3
    v_lshl_add_u32 v26, v74, 3, v73
    v_lshlrev_b32 v26, 2, v26
    ds_add_rtn_u32 v106, v26, v3
    v_and_b32 v73, 15, v97
    v_lshlrev_b32 v73, v73, v126
    v_mul_u32_u24 v74, s44, v74
    v_lshl_or_b32 v97, v73, 16, v74
    s_waitcnt vmcnt(0)
    s_mov_b64 exec, s[62:63]
    s_cbranch_execz A_RK7
    v_subrev_u32 v99, s29, v99
    v_mad_u32_u16 v73, v98, 21, s69
    v_lshrrev_b32 v74, 4, v99
    v_bfe_u32 v73, v73, 17, 3
    v_lshl_add_u32 v27, v74, 3, v73
    v_lshlrev_b32 v27, 2, v27
    ds_add_rtn_u32 v107, v27, v3
    v_and_b32 v73, 15, v99
    v_lshlrev_b32 v73, v73, v126
    v_mul_u32_u24 v74, s44, v74
    v_lshl_or_b32 v99, v73, 16, v74
A_RK7:
    s_mov_b64 exec, -1
    s_waitcnt lgkmcnt(0)
    s_barrier
    s_mov_b32 s38, 0
    s_cmp_ge_u32 s31, s30
    s_cbranch_scc1 A_NOSCAN
    s_lshl_b32 s42, s31, 5
    v_lshlrev_b32 v73, 2, v1
    v_add_u32 v73, s42, v73
    v_mov_b32 v74, 0
    s_mov_b64 exec, 0xff
    ds_read_b32 v74, v73 offset:0
    s_mov_b64 exec, -1
    s_sub_u32 s43, s35, 1024
    s_waitcnt lgkmcnt(0)
    v_mov_b32 v75, v74
    s_nop 1
    v_add_u32_dpp v75, v75, v75 row_shr:1 row_mask:0xf bank_mask:0xf bound_ctrl:0
    s_nop 1
    v_add_u32_dpp v75, v75, v75 row_shr:2 row_mask:0xf bank_mask:0xf bound_ctrl:0
    s_nop 1
    v_add_u32_dpp v75, v75, v75 row_shr:4 row_mask:0xf bank_mask:0xf bound_ctrl:0
    s_nop 1
    v_sub_u32 v76, v75, v74
    v_readlane_b32 s38, v75, 7
    v_add_u32 v76, s43, v76
    s_mov_b64 exec, 0xff
    ds_write_b32 v73, v76 offset:0
    s_lshr_b32 s38, s38, 2
    s_mov_b64 exec, 1
    v_mov_b32 v73, 512
    v_mov_b32 v74, s38
    ds_max_u32 v73, v74
    s_mov_b64 exec, -1
A_NOSCAN:
    s_mov_b32 s37, 0
    s_sub_i32 s42, s38, s37
    s_max_i32 s42, s42, 0
    s_min_i32 s42, s42, 384
    s_add_u32 s39, s42, 31
    s_lshr_b32 s39, s39, 5
    s_lshl_b32 s43, s39, 5
    v_add_u32 v73, s42, v1
    v_cmp_gt_u32 vcc, s43, v73
    s_sub_u32 s43, s35, 1024
    v_lshl_add_u32 v74, v73, 2, s43
    v_lshrrev_b32 v75, 1, v74
    v_mov_b32 v76, 0xffff
    s_mov_b64 exec, vcc
    ds_write_b32 v74, v76 offset:1024
    ds_write_b16 v75, v127 offset:20992
    s_mov_b64 exec, -1
    s_waitcnt lgkmcnt(0)
    s_barrier
    v_mov_b32 v73, 512
    ds_read_b64 v[74:75], v73
    s_mov_b64 exec, s[48:49]
    ds_read_b32 v20, v20
    s_mov_b64 exec, s[50:51]
    ds_read_b32 v21, v21
    s_mov_b64 exec, s[52:53]
    ds_read_b32 v22, v22
    s_mov_b64 exec, s[54:55]
    ds_read_b32 v23, v23
    s_mov_b64 exec, s[56:57]
    ds_read_b32 v24, v24
    s_mov_b64 exec, s[58:59]
    ds_read_b32 v25, v25
    s_mov_b64 exec, s[60:61]
    ds_read_b32 v26, v26
    s_mov_b64 exec, s[62:63]
    ds_read_b32 v27, v27
    s_mov_b64 exec, -1
    s_waitcnt lgkmcnt(0)
    v_readfirstlane_b32 s40, v74
    v_readfirstlane_b32 s41, v75
    s_cmp_gt_u32 s40, 384
    s_cbranch_scc1 A_SLOWSC
    s_mov_b64 exec, s[48:49]
    v_add_u32 v100, v100, v20
    v_lshrrev_b32 v20, 1, v100
    ds_write_b32 v100, v84 offset:1024
    ds_write_b16_d16_hi v20, v85 offset:20992
    s_mov_b64 exec, s[50:51]
    s_cbranch_execz A_FS1
    v_add_u32 v101, v101, v21
    v_lshrrev_b32 v21, 1, v101
    ds_write_b32 v101, v86 offset:1024
    ds_write_b16_d16_hi v21, v87 offset:20992
A_FS1:
    s_mov_b64 exec, s[52:53]
    v_add_u32 v102, v102, v22
    v_lshrrev_b32 v22, 1, v102
    ds_write_b32 v102, v88 offset:1024
    ds_write_b16_d16_hi v22, v89 offset:20992
    s_mov_b64 exec, s[54:55]
    s_cbranch_execz A_FS3
    v_add_u32 v103, v103, v23
    v_lshrrev_b32 v23, 1, v103
    ds_write_b32 v103, v90 offset:1024
    ds_write_b16_d16_hi v23, v91 offset:20992
A_FS3:
    s_mov_b64 exec, s[56:57]
    v_add_u32 v104, v104, v24
    v_lshrrev_b32 v24, 1, v104
    ds_write_b32 v104, v92 offset:1024
    ds_write_b16_d16_hi v24, v93 offset:20992
    s_mov_b64 exec, s[58:59]
    s_cbranch_execz A_FS5
    v_add_u32 v105, v105, v25
    v_lshrrev_b32 v25, 1, v105
    ds_write_b32 v105, v94 offset:1024
    ds_write_b16_d16_hi v25, v95 offset:20992
A_FS5:
    s_mov_b64 exec, s[60:61]
    v_add_u32 v106, v106, v26
    v_lshrrev_b32 v26, 1, v106
    ds_write_b32 v106, v96 offset:1024
    ds_write_b16_d16_hi v26, v97 offset:20992
    s_mov_b64 exec, s[62:63]
    s_cbranch_execz A_FS7
    v_add_u32 v107, v107, v27
    v_lshrrev_b32 v27, 1, v107
    ds_write_b32 v107, v98 offset:1024
    ds_write_b16_d16_hi v27, v99 offset:20992
A_FS7:
    s_mov_b64 exec, -1
    s_branch A_SCDONE
A_SLOWSC:
    v_add_u32 v100, v100, v20
    v_add_u32 v101, v101, v21
    v_add_u32 v102, v102, v22
    v_add_u32 v103, v103, v23
    v_add_u32 v104, v104, v24
    v_add_u32 v105, v105, v25
    v_add_u32 v106, v106, v26
    v_add_u32 v107, v107, v27
A_SUB:
    s_lshl_b32 s42, s37, 2
    v_and_b32 v74, 0xffff, v85
    v_subrev_u32 v73, s42, v100
    v_sub_u32 v74, v73, v74
    v_cmp_gt_u32 vcc, 1536, v74
    v_lshrrev_b32 v75, 1, v73
    s_and_b64 exec, vcc, s[48:49]
    ds_write_b32 v73, v84 offset:1024
    ds_write_b16_d16_hi v75, v85 offset:20992
    s_mov_b64 exec, -1
    v_and_b32 v74, 0xffff, v87
    v_subrev_u32 v73, s42, v101
    v_sub_u32 v74, v73, v74
    v_cmp_gt_u32 vcc, 1536, v74
    v_lshrrev_b32 v75, 1, v73
    s_and_b64 exec, vcc, s[50:51]
    ds_write_b32 v73, v86 offset:1024
    ds_write_b16_d16_hi v75, v87 offset:20992
    s_mov_b64 exec, -1
    v_and_b32 v74, 0xffff, v89
    v_subrev_u32 v73, s42, v102
    v_sub_u32 v74, v73, v74
    v_cmp_gt_u32 vcc, 1536, v74
    v_lshrrev_b32 v75, 1, v73
    s_and_b64 exec, vcc, s[52:53]
    ds_write_b32 v73, v88 offset:1024
    ds_write_b16_d16_hi v75, v89 offset:20992
    s_mov_b64 exec, -1
    v_and_b32 v74, 0xffff, v91
    v_subrev_u32 v73, s42, v103
    v_sub_u32 v74, v73, v74
    v_cmp_gt_u32 vcc, 1536, v74
    v_lshrrev_b32 v75, 1, v73
    s_and_b64 exec, vcc, s[54:55]
    ds_write_b32 v73, v90 offset:1024
    ds_write_b16_d16_hi v75, v91 offset:20992
    s_mov_b64 exec, -1
    v_and_b32 v74, 0xffff, v93
    v_subrev_u32 v73, s42, v104
    v_sub_u32 v74, v73, v74
    v_cmp_gt_u32 vcc, 1536, v74
    v_lshrrev_b32 v75, 1, v73
    s_and_b64 exec, vcc, s[56:57]
    ds_write_b32 v73, v92 offset:1024
    ds_write_b16_d16_hi v75, v93 offset:20992
    s_mov_b64 exec, -1
    v_and_b32 v74, 0xffff, v95
    v_subrev_u32 v73, s42, v105
    v_sub_u32 v74, v73, v74
    v_cmp_gt_u32 vcc, 1536, v74
    v_lshrrev_b32 v75, 1, v73
    s_and_b64 exec, vcc, s[58:59]
    ds_write_b32 v73, v94 offset:1024
    ds_write_b16_d16_hi v75, v95 offset:20992
    s_mov_b64 exec, -1
    v_and_b32 v74, 0xffff, v97
    v_subrev_u32 v73, s42, v106
    v_sub_u32 v74, v73, v74
    v_cmp_gt_u32 vcc, 1536, v74
    v_lshrrev_b32 v75, 1, v73
    s_and_b64 exec, vcc, s[60:61]
    ds_write_b32 v73, v96 offset:1024
    ds_write_b16_d16_hi v75, v97 offset:20992
    s_mov_b64 exec, -1
    v_and_b32 v74, 0xffff, v99
    v_subrev_u32 v73, s42, v107
    v_sub_u32 v74, v73, v74
    v_cmp_gt_u32 vcc, 1536, v74
    v_lshrrev_b32 v75, 1, v73
    s_and_b64 exec, vcc, s[62:63]
    ds_write_b32 v73, v98 offset:1024
    ds_write_b16_d16_hi v75, v99 offset:20992
    s_mov_b64 exec, -1
    s_sub_i32 s42, s38, s37
    s_max_i32 s42, s42, 0
    s_min_i32 s42, s42, 384
    s_add_u32 s39, s42, 31
    s_lshr_b32 s39, s39, 5
    s_lshl_b32 s43, s39, 5
    v_add_u32 v73, s42, v1
    v_cmp_gt_u32 vcc, s43, v73
    s_sub_u32 s43, s35, 1024
    v_lshl_add_u32 v74, v73, 2, s43
    v_lshrrev_b32 v75, 1, v74
    v_mov_b32 v76, 0xffff
    s_mov_b64 exec, vcc
    ds_write_b32 v74, v76 offset:1024
    ds_write_b16 v75, v127 offset:20992
    s_mov_b64 exec, -1
A_SCDONE:
    s_bfm_b32 s72, s39, 0
    s_waitcnt lgkmcnt(0)
    s_barrier
A_ML:
    s_bcnt1_i32_b32 s39, s72
    s_cmp_eq_u32 s39, 0
    s_cbranch_scc1 AG_DONE
    s_setprio 3
    s_ff1_i32_b32 s76, s72
    s_max_i32 s76, s76, 0
    s_bitset0_b32 s72, s76
    s_lshl_b32 s76, s76, 7
    v_add_u32 v73, s76, v68
    ds_read_b128 v[52:55], v73
    s_ff1_i32_b32 s77, s72
    s_max_i32 s77, s77, 0
    s_bitset0_b32 s72, s77
    s_lshl_b32 s77, s77, 7
    v_add_u32 v74, s77, v68
    ds_read_b128 v[40:43], v74
    s_ff1_i32_b32 s78, s72
    s_max_i32 s78, s78, 0
    s_bitset0_b32 s72, s78
    s_lshl_b32 s78, s78, 7
    s_waitcnt lgkmcnt(1)
    s_add_u32 m0, s34, 0
    v_mad_u32_u16 v56, v52, s32, v60
    buffer_load_dwordx4 v56, s[12:15], 0 offen lds
    s_add_u32 m0, s34, 1024
    v_mad_u32_u16 v57, v53, s32, v61
    buffer_load_dwordx4 v57, s[12:15], 0 offen lds
    s_add_u32 m0, s34, 2048
    v_mad_u32_u16 v58, v54, s32, v62
    buffer_load_dwordx4 v58, s[12:15], 0 offen lds
    s_add_u32 m0, s34, 3072
    v_mad_u32_u16 v59, v55, s32, v63
    buffer_load_dwordx4 v59, s[12:15], 0 offen lds
    s_cmp_lt_u32 s39, 2
    s_cbranch_scc1 AG_LOOP0
    s_waitcnt lgkmcnt(0)
    s_add_u32 m0, s34, 4096
    v_mad_u32_u16 v56, v40, s32, v60
    buffer_load_dwordx4 v56, s[12:15], 0 offen lds
    s_add_u32 m0, s34, 5120
    v_mad_u32_u16 v57, v41, s32, v61
    buffer_load_dwordx4 v57, s[12:15], 0 offen lds
    s_add_u32 m0, s34, 6144
    v_mad_u32_u16 v58, v42, s32, v62
    buffer_load_dwordx4 v58, s[12:15], 0 offen lds
    s_add_u32 m0, s34, 7168
    v_mad_u32_u16 v59, v43, s32, v63
    buffer_load_dwordx4 v59, s[12:15], 0 offen lds
AG_LOOP0:
    s_lshr_b32 s42, s76, 1
    v_add_u32 v73, s76, v69
    v_add_u32 v74, s42, v70
    v_add_u32 v75, s78, v68
    ds_read_b128 v[40:43], v73
    ds_read_b128 v[44:47], v73 offset:16
    ds_read_b128 v[48:51], v74
    ds_read_b128 v[52:55], v75
    s_mov_b32 s76, s77
    s_mov_b32 s77, s78
    s_ff1_i32_b32 s78, s72
    s_max_i32 s78, s78, 0
    s_bitset0_b32 s72, s78
    s_lshl_b32 s78, s78, 7
    s_cmp_eq_u32 s39, 7
    s_cbranch_scc0 AG_PR0_7
    s_setprio 2
AG_PR0_7:
    s_cmp_eq_u32 s39, 5
    s_cbranch_scc0 AG_PR0_5
    s_setprio 1
AG_PR0_5:
    s_cmp_eq_u32 s39, 3
    s_cbranch_scc0 AG_PR0_3
    s_setprio 0
AG_PR0_3:
    s_cmp_eq_u32 s39, 1
    s_cbranch_scc1 AG_W0_0
    s_waitcnt vmcnt(4)
    s_branch AG_W1_0
AG_W0_0:
    s_waitcnt vmcnt(0)
AG_W1_0:
    ds_read_b64_tr_b16 v[20:21], v64 offset:0
    ds_read_b64_tr_b16 v[22:23], v64 offset:256
    ds_read_b64_tr_b16 v[24:25], v65 offset:0
    ds_read_b64_tr_b16 v[26:27], v65 offset:256
    ds_read_b64_tr_b16 v[28:29], v66 offset:0
    ds_read_b64_tr_b16 v[30:31], v66 offset:256
    ds_read_b64_tr_b16 v[32:33], v67 offset:0
    ds_read_b64_tr_b16 v[34:35], v67 offset:256
    s_waitcnt lgkmcnt(9)
    v_pk_lshlrev_b16 v36, v71, v48
    v_perm_b32 v40, v41, v40, s68
    v_pk_lshlrev_b16 v37, v71, v49
    v_perm_b32 v42, v43, v42, s68
    v_pk_lshlrev_b16 v38, v71, v50
    v_perm_b32 v44, v45, v44, s68
    v_pk_lshlrev_b16 v39, v71, v51
    v_perm_b32 v46, v47, v46, s68
    v_pk_ashrrev_i16 v36, s33, v36
    v_pk_ashrrev_i16 v37, s33, v37
    v_pk_ashrrev_i16 v38, s33, v38
    v_pk_ashrrev_i16 v39, s33, v39
    v_and_b32 v36, v36, v40
    v_and_b32 v37, v37, v42
    v_and_b32 v38, v38, v44
    v_and_b32 v39, v39, v46
    s_waitcnt lgkmcnt(0)
    s_cmp_lt_u32 s39, 3
    s_cbranch_scc1 AG_NI_0
    s_add_u32 m0, s34, 0
    v_mad_u32_u16 v56, v52, s32, v60
    buffer_load_dwordx4 v56, s[12:15], 0 offen lds
    s_add_u32 m0, s34, 1024
    v_mad_u32_u16 v57, v53, s32, v61
    buffer_load_dwordx4 v57, s[12:15], 0 offen lds
    s_add_u32 m0, s34, 2048
    v_mad_u32_u16 v58, v54, s32, v62
    buffer_load_dwordx4 v58, s[12:15], 0 offen lds
    s_add_u32 m0, s34, 3072
    v_mad_u32_u16 v59, v55, s32, v63
    buffer_load_dwordx4 v59, s[12:15], 0 offen lds
AG_NI_0:
    v_mfma_f32_16x16x32_bf16 v[4:7], v[20:23], v[36:39], v[4:7]
    v_mfma_f32_16x16x32_bf16 v[8:11], v[24:27], v[36:39], v[8:11]
    v_mfma_f32_16x16x32_bf16 v[12:15], v[28:31], v[36:39], v[12:15]
    v_mfma_f32_16x16x32_bf16 v[16:19], v[32:35], v[36:39], v[16:19]
    s_sub_u32 s39, s39, 1
    s_cmp_eq_u32 s39, 0
    s_cbranch_scc1 AG_DONE
AG_LOOP1:
    s_lshr_b32 s42, s76, 1
    v_add_u32 v73, s76, v69
    v_add_u32 v74, s42, v70
    v_add_u32 v75, s78, v68
    ds_read_b128 v[40:43], v73
    ds_read_b128 v[44:47], v73 offset:16
    ds_read_b128 v[48:51], v74
    ds_read_b128 v[52:55], v75
    s_mov_b32 s76, s77
    s_mov_b32 s77, s78
    s_ff1_i32_b32 s78, s72
    s_max_i32 s78, s78, 0
    s_bitset0_b32 s72, s78
    s_lshl_b32 s78, s78, 7
    s_cmp_eq_u32 s39, 7
    s_cbranch_scc0 AG_PR1_7
    s_setprio 2
AG_PR1_7:
    s_cmp_eq_u32 s39, 5
    s_cbranch_scc0 AG_PR1_5
    s_setprio 1
AG_PR1_5:
    s_cmp_eq_u32 s39, 3
    s_cbranch_scc0 AG_PR1_3
    s_setprio 0
AG_PR1_3:
    s_cmp_eq_u32 s39, 1
    s_cbranch_scc1 AG_W0_1
    s_waitcnt vmcnt(4)
    s_branch AG_W1_1
AG_W0_1:
    s_waitcnt vmcnt(0)
AG_W1_1:
    ds_read_b64_tr_b16 v[20:21], v64 offset:4096
    ds_read_b64_tr_b16 v[22:23], v64 offset:4352
    ds_read_b64_tr_b16 v[24:25], v65 offset:4096
    ds_read_b64_tr_b16 v[26:27], v65 offset:4352
    ds_read_b64_tr_b16 v[28:29], v66 offset:4096
    ds_read_b64_tr_b16 v[30:31], v66 offset:4352
    ds_read_b64_tr_b16 v[32:33], v67 offset:4096
    ds_read_b64_tr_b16 v[34:35], v67 offset:4352
    s_waitcnt lgkmcnt(9)
    v_pk_lshlrev_b16 v36, v71, v48
    v_perm_b32 v40, v41, v40, s68
    v_pk_lshlrev_b16 v37, v71, v49
    v_perm_b32 v42, v43, v42, s68
    v_pk_lshlrev_b16 v38, v71, v50
    v_perm_b32 v44, v45, v44, s68
    v_pk_lshlrev_b16 v39, v71, v51
    v_perm_b32 v46, v47, v46, s68
    v_pk_ashrrev_i16 v36, s33, v36
    v_pk_ashrrev_i16 v37, s33, v37
    v_pk_ashrrev_i16 v38, s33, v38
    v_pk_ashrrev_i16 v39, s33, v39
    v_and_b32 v36, v36, v40
    v_and_b32 v37, v37, v42
    v_and_b32 v38, v38, v44
    v_and_b32 v39, v39, v46
    s_waitcnt lgkmcnt(0)
    s_cmp_lt_u32 s39, 3
    s_cbranch_scc1 AG_NI_1
    s_add_u32 m0, s34, 4096
    v_mad_u32_u16 v56, v52, s32, v60
    buffer_load_dwordx4 v56, s[12:15], 0 offen lds
    s_add_u32 m0, s34, 5120
    v_mad_u32_u16 v57, v53, s32, v61
    buffer_load_dwordx4 v57, s[12:15], 0 offen lds
    s_add_u32 m0, s34, 6144
    v_mad_u32_u16 v58, v54, s32, v62
    buffer_load_dwordx4 v58, s[12:15], 0 offen lds
    s_add_u32 m0, s34, 7168
    v_mad_u32_u16 v59, v55, s32, v63
    buffer_load_dwordx4 v59, s[12:15], 0 offen lds
AG_NI_1:
    v_mfma_f32_16x16x32_bf16 v[4:7], v[20:23], v[36:39], v[4:7]
    v_mfma_f32_16x16x32_bf16 v[8:11], v[24:27], v[36:39], v[8:11]
    v_mfma_f32_16x16x32_bf16 v[12:15], v[28:31], v[36:39], v[12:15]
    v_mfma_f32_16x16x32_bf16 v[16:19], v[32:35], v[36:39], v[16:19]
    s_sub_u32 s39, s39, 1
    s_cmp_eq_u32 s39, 0
    s_cbranch_scc1 AG_DONE
    s_branch AG_LOOP0
AG_DONE:
    s_setprio 0
    s_add_u32 s66, s66, 1
    s_add_u32 s37, s37, 384
    s_cmp_lt_u32 s37, s40
    s_cbranch_scc0 A_SUBDONE
    s_barrier
    s_branch A_SUB
A_SUBDONE:
    s_cmp_eq_u32 s41, 0
    s_cbranch_scc1 A_WINDONE
    s_add_u32 s36, s36, 32
    s_barrier
    s_branch A_WIN
A_WINDONE:
    s_cmp_eq_u32 s70, 2
    s_cbranch_scc1 EPI
    s_cmp_ge_u32 s31, s30
    s_cbranch_scc1 T1_DONE
    s_nop 7
    v_cvt_pk_bf16_f32 v116, v4, v5
    v_cvt_pk_bf16_f32 v117, v6, v7
    v_cvt_pk_bf16_f32 v118, v8, v9
    v_cvt_pk_bf16_f32 v119, v10, v11
    v_cvt_pk_bf16_f32 v120, v12, v13
    v_cvt_pk_bf16_f32 v121, v14, v15
    v_cvt_pk_bf16_f32 v122, v16, v17
    v_cvt_pk_bf16_f32 v123, v18, v19
    v_and_b32 v73, 15, v1
    v_lshlrev_b32 v73, 7, v73
    v_and_b32 v74, 48, v1
    v_lshl_add_u32 v73, v74, 1, v73
    v_add_u32 v73, s34, v73
    ds_write_b128 v73, v[116:119]
    ds_write_b128 v73, v[120:123] offset:16
    v_add_u32 v74, s34, v72
    s_add_u32 s42, s75, 7340032
    s_sub_i32 s43, s74, 1024
    v_cmp_gt_i32 vcc, s43, v72
    v_cmp_gt_i32 s[64:65], s74, v72
    s_waitcnt lgkmcnt(0)
    ds_read_b128 v[20:23], v74
    ds_read_b128 v[24:27], v74 offset:1024
    s_mov_b64 exec, s[64:65]
    s_waitcnt lgkmcnt(1)
    buffer_store_dwordx4 v[20:23], v72, s[16:19], s42 offen sc1
    s_mov_b64 exec, vcc
    s_cbranch_execz TS1
    s_waitcnt lgkmcnt(0)
    buffer_store_dwordx4 v[24:27], v72, s[16:19], s42 offen offset:1024 sc1
TS1:
    s_mov_b64 exec, -1
T1_DONE:
    v_mov_b32 v4, 0
    v_mov_b32 v5, 0
    v_mov_b32 v6, 0
    v_mov_b32 v7, 0
    v_mov_b32 v8, 0
    v_mov_b32 v9, 0
    v_mov_b32 v10, 0
    v_mov_b32 v11, 0
    v_mov_b32 v12, 0
    v_mov_b32 v13, 0
    v_mov_b32 v14, 0
    v_mov_b32 v15, 0
    v_mov_b32 v16, 0
    v_mov_b32 v17, 0
    v_mov_b32 v18, 0
    v_mov_b32 v19, 0
    s_add_u32 s12, s6, 7340032
    s_addc_u32 s13, s7, 0
    s_and_b32 s13, s13, 0xffff
    s_mov_b32 s14, 6400000
    s_mov_b32 s15, 0x00020000
    s_mov_b32 s70, 2
    s_waitcnt vmcnt(0) lgkmcnt(0)
    s_barrier
    s_cmp_eq_u32 s31, 15
    s_cbranch_scc1 GB1_POLL
    s_cmp_ge_u32 s31, s30
    s_cbranch_scc1 B2_END
    s_cmp_eq_u32 s73, 1
    s_cbranch_scc0 B2_END
    v_add_u32 v74, 30976, v72
    ds_read_b128 v[20:23], v74 offset:0
    ds_read_b128 v[24:27], v74 offset:1024
    ds_read_b128 v[28:31], v74 offset:2048
    ds_read_b128 v[32:35], v74 offset:3072
    ds_read_b128 v[36:39], v74 offset:4096
    ds_read_b128 v[40:43], v74 offset:5120
    ds_read_b128 v[44:47], v74 offset:6144
    ds_read_b128 v[48:51], v74 offset:7168
    s_waitcnt lgkmcnt(4)
    v_mfma_f32_16x16x32_bf16 v[84:87], v[20:23], v[108:111], 0
    v_mfma_f32_16x16x32_bf16 v[88:91], v[24:27], v[108:111], 0
    v_mfma_f32_16x16x32_bf16 v[92:95], v[28:31], v[108:111], 0
    v_mfma_f32_16x16x32_bf16 v[96:99], v[32:35], v[108:111], 0
    ds_read_b128 v[20:23], v74 offset:8192
    ds_read_b128 v[24:27], v74 offset:9216
    ds_read_b128 v[28:31], v74 offset:10240
    ds_read_b128 v[32:35], v74 offset:11264
    s_waitcnt lgkmcnt(4)
    v_mfma_f32_16x16x32_bf16 v[84:87], v[36:39], v[112:115], v[84:87]
    v_mfma_f32_16x16x32_bf16 v[88:91], v[40:43], v[112:115], v[88:91]
    v_mfma_f32_16x16x32_bf16 v[92:95], v[44:47], v[112:115], v[92:95]
    v_mfma_f32_16x16x32_bf16 v[96:99], v[48:51], v[112:115], v[96:99]
    ds_read_b128 v[36:39], v74 offset:12288
    ds_read_b128 v[40:43], v74 offset:13312
    ds_read_b128 v[44:47], v74 offset:14336
    ds_read_b128 v[48:51], v74 offset:15360
    s_waitcnt lgkmcnt(4)
    v_mfma_f32_16x16x32_bf16 v[84:87], v[20:23], v[116:119], v[84:87]
    v_mfma_f32_16x16x32_bf16 v[88:91], v[24:27], v[116:119], v[88:91]
    v_mfma_f32_16x16x32_bf16 v[92:95], v[28:31], v[116:119], v[92:95]
    v_mfma_f32_16x16x32_bf16 v[96:99], v[32:35], v[116:119], v[96:99]
    s_waitcnt lgkmcnt(0)
    v_mfma_f32_16x16x32_bf16 v[84:87], v[36:39], v[120:123], v[84:87]
    v_mfma_f32_16x16x32_bf16 v[88:91], v[40:43], v[120:123], v[88:91]
    v_mfma_f32_16x16x32_bf16 v[92:95], v[44:47], v[120:123], v[92:95]
    v_mfma_f32_16x16x32_bf16 v[96:99], v[48:51], v[120:123], v[96:99]
B2_END:
    s_branch GB1_JOIN
GB1_POLL:
    s_mov_b64 exec, 1
    s_and_b32 s42, s2, 1
    s_lshl_b32 s42, s42, 6
    s_add_u32 s42, s42, 16
    v_mov_b32 v73, s42
    v_mov_b32 v74, 144
    global_atomic_add v75, v73, v126, s[10:11] sc0 sc1
    s_waitcnt vmcnt(0)
    v_readfirstlane_b32 s42, v75
    s_cmp_eq_u32 s42, 127
    s_cbranch_scc0 GB1_SPIN0
    global_atomic_add v74, v126, s[10:11] sc1
GB1_SPIN0:
    s_mov_b32 s71, 0
GB1_SPIN:
    global_load_dword v75, v74, s[10:11] sc1
    s_waitcnt vmcnt(0)
    v_readfirstlane_b32 s42, v75
    s_cmp_ge_u32 s42, 2
    s_cbranch_scc1 GB1_DONE
    s_add_u32 s71, s71, 1
    s_cmp_ge_u32 s71, 0x400000
    s_cbranch_scc1 GB1_DONE
    s_sleep 2
    s_branch GB1_SPIN
GB1_DONE:
    s_mov_b64 exec, -1
GB1_JOIN:
    s_barrier
    s_cmp_eq_u32 s73, 1
    s_cbranch_scc0 A_START
    s_mov_b32 s72, s67
    s_mov_b32 s40, 0
    s_mov_b32 s41, 0
    s_branch A_ML
EPI:
    s_cmp_ge_u32 s31, s30
    s_cbranch_scc1 K_END
    s_cmp_eq_u32 s73, 1
    s_cbranch_scc1 EPI2
    v_add_u32 v74, 30976, v72
    ds_read_b128 v[20:23], v74 offset:0
    ds_read_b128 v[24:27], v74 offset:1024
    ds_read_b128 v[28:31], v74 offset:2048
    ds_read_b128 v[32:35], v74 offset:3072
    ds_read_b128 v[36:39], v74 offset:4096
    ds_read_b128 v[40:43], v74 offset:5120
    ds_read_b128 v[44:47], v74 offset:6144
    ds_read_b128 v[48:51], v74 offset:7168
    s_waitcnt lgkmcnt(4)
    v_mfma_f32_16x16x32_bf16 v[84:87], v[20:23], v[108:111], 0
    v_mfma_f32_16x16x32_bf16 v[88:91], v[24:27], v[108:111], 0
    v_mfma_f32_16x16x32_bf16 v[92:95], v[28:31], v[108:111], 0
    v_mfma_f32_16x16x32_bf16 v[96:99], v[32:35], v[108:111], 0
    ds_read_b128 v[20:23], v74 offset:8192
    ds_read_b128 v[24:27], v74 offset:9216
    ds_read_b128 v[28:31], v74 offset:10240
    ds_read_b128 v[32:35], v74 offset:11264
    s_waitcnt lgkmcnt(4)
    v_mfma_f32_16x16x32_bf16 v[84:87], v[36:39], v[112:115], v[84:87]
    v_mfma_f32_16x16x32_bf16 v[88:91], v[40:43], v[112:115], v[88:91]
    v_mfma_f32_16x16x32_bf16 v[92:95], v[44:47], v[112:115], v[92:95]
    v_mfma_f32_16x16x32_bf16 v[96:99], v[48:51], v[112:115], v[96:99]
    ds_read_b128 v[36:39], v74 offset:12288
    ds_read_b128 v[40:43], v74 offset:13312
    ds_read_b128 v[44:47], v74 offset:14336
    ds_read_b128 v[48:51], v74 offset:15360
    s_waitcnt lgkmcnt(4)
    v_mfma_f32_16x16x32_bf16 v[84:87], v[20:23], v[116:119], v[84:87]
    v_mfma_f32_16x16x32_bf16 v[88:91], v[24:27], v[116:119], v[88:91]
    v_mfma_f32_16x16x32_bf16 v[92:95], v[28:31], v[116:119], v[92:95]
    v_mfma_f32_16x16x32_bf16 v[96:99], v[32:35], v[116:119], v[96:99]
    s_waitcnt lgkmcnt(0)
    v_mfma_f32_16x16x32_bf16 v[84:87], v[36:39], v[120:123], v[84:87]
    v_mfma_f32_16x16x32_bf16 v[88:91], v[40:43], v[120:123], v[88:91]
    v_mfma_f32_16x16x32_bf16 v[92:95], v[44:47], v[120:123], v[92:95]
    v_mfma_f32_16x16x32_bf16 v[96:99], v[48:51], v[120:123], v[96:99]
EPI2:
    v_add_u32 v74, 30976, v72
    ds_read_b128 v[20:23], v74 offset:16384
    ds_read_b128 v[24:27], v74 offset:17408
    ds_read_b128 v[28:31], v74 offset:18432
    ds_read_b128 v[32:35], v74 offset:19456
    ds_read_b128 v[36:39], v74 offset:20480
    ds_read_b128 v[40:43], v74 offset:21504
    ds_read_b128 v[44:47], v74 offset:22528
    ds_read_b128 v[48:51], v74 offset:23552
    s_mov_b32 s44, 0xffff0000
    s_nop 3
    v_cvt_pk_bf16_f32 v52, v4, v5
    v_lshlrev_b32 v53, 16, v108
    v_and_b32 v54, s44, v108
    v_lshlrev_b32 v55, 16, v52
    v_and_b32 v56, s44, v52
    v_fma_f32 v55, 2.0, v55, -v53
    v_fma_f32 v56, 2.0, v56, -v54
    v_cvt_pk_bf16_f32 v100, v55, v56
    v_cvt_pk_bf16_f32 v52, v6, v7
    v_lshlrev_b32 v53, 16, v109
    v_and_b32 v54, s44, v109
    v_lshlrev_b32 v55, 16, v52
    v_and_b32 v56, s44, v52
    v_fma_f32 v55, 2.0, v55, -v53
    v_fma_f32 v56, 2.0, v56, -v54
    v_cvt_pk_bf16_f32 v101, v55, v56
    v_cvt_pk_bf16_f32 v52, v8, v9
    v_lshlrev_b32 v53, 16, v110
    v_and_b32 v54, s44, v110
    v_lshlrev_b32 v55, 16, v52
    v_and_b32 v56, s44, v52
    v_fma_f32 v55, 2.0, v55, -v53
    v_fma_f32 v56, 2.0, v56, -v54
    v_cvt_pk_bf16_f32 v102, v55, v56
    v_cvt_pk_bf16_f32 v52, v10, v11
    v_lshlrev_b32 v53, 16, v111
    v_and_b32 v54, s44, v111
    v_lshlrev_b32 v55, 16, v52
    v_and_b32 v56, s44, v52
    v_fma_f32 v55, 2.0, v55, -v53
    v_fma_f32 v56, 2.0, v56, -v54
    v_cvt_pk_bf16_f32 v103, v55, v56
    v_cvt_pk_bf16_f32 v52, v12, v13
    v_lshlrev_b32 v53, 16, v112
    v_and_b32 v54, s44, v112
    v_lshlrev_b32 v55, 16, v52
    v_and_b32 v56, s44, v52
    v_fma_f32 v55, 2.0, v55, -v53
    v_fma_f32 v56, 2.0, v56, -v54
    v_cvt_pk_bf16_f32 v104, v55, v56
    v_cvt_pk_bf16_f32 v52, v14, v15
    v_lshlrev_b32 v53, 16, v113
    v_and_b32 v54, s44, v113
    v_lshlrev_b32 v55, 16, v52
    v_and_b32 v56, s44, v52
    v_fma_f32 v55, 2.0, v55, -v53
    v_fma_f32 v56, 2.0, v56, -v54
    v_cvt_pk_bf16_f32 v105, v55, v56
    v_cvt_pk_bf16_f32 v52, v16, v17
    v_lshlrev_b32 v53, 16, v114
    v_and_b32 v54, s44, v114
    v_lshlrev_b32 v55, 16, v52
    v_and_b32 v56, s44, v52
    v_fma_f32 v55, 2.0, v55, -v53
    v_fma_f32 v56, 2.0, v56, -v54
    v_cvt_pk_bf16_f32 v106, v55, v56
    v_cvt_pk_bf16_f32 v52, v18, v19
    v_lshlrev_b32 v53, 16, v115
    v_and_b32 v54, s44, v115
    v_lshlrev_b32 v55, 16, v52
    v_and_b32 v56, s44, v52
    v_fma_f32 v55, 2.0, v55, -v53
    v_fma_f32 v56, 2.0, v56, -v54
    v_cvt_pk_bf16_f32 v107, v55, v56
    s_waitcnt lgkmcnt(0)
    s_nop 1
    v_mfma_f32_16x16x32_bf16 v[84:87], v[20:23], v[100:103], v[84:87]
    v_mfma_f32_16x16x32_bf16 v[88:91], v[24:27], v[100:103], v[88:91]
    v_mfma_f32_16x16x32_bf16 v[92:95], v[28:31], v[100:103], v[92:95]
    v_mfma_f32_16x16x32_bf16 v[96:99], v[32:35], v[100:103], v[96:99]
    v_mfma_f32_16x16x32_bf16 v[84:87], v[36:39], v[104:107], v[84:87]
    v_mfma_f32_16x16x32_bf16 v[88:91], v[40:43], v[104:107], v[88:91]
    v_mfma_f32_16x16x32_bf16 v[92:95], v[44:47], v[104:107], v[92:95]
    v_mfma_f32_16x16x32_bf16 v[96:99], v[48:51], v[104:107], v[96:99]
    s_nop 7
    s_nop 3
    v_cvt_pk_bf16_f32 v4, v84, v85
    v_cvt_pk_bf16_f32 v5, v86, v87
    v_cvt_pk_bf16_f32 v6, v88, v89
    v_cvt_pk_bf16_f32 v7, v90, v91
    v_cvt_pk_bf16_f32 v8, v92, v93
    v_cvt_pk_bf16_f32 v9, v94, v95
    v_cvt_pk_bf16_f32 v10, v96, v97
    v_cvt_pk_bf16_f32 v11, v98, v99
    v_and_b32 v73, 15, v1
    v_lshlrev_b32 v73, 7, v73
    v_and_b32 v74, 48, v1
    v_lshl_add_u32 v73, v74, 1, v73
    v_add_u32 v73, s34, v73
    ds_write_b128 v73, v[4:7]
    ds_write_b128 v73, v[8:11] offset:16
    v_add_u32 v74, s34, v72
    s_add_u32 s42, s75, 0
    s_sub_i32 s43, s74, 1024
    v_cmp_gt_i32 vcc, s43, v72
    v_cmp_gt_i32 s[64:65], s74, v72
    s_waitcnt lgkmcnt(0)
    ds_read_b128 v[20:23], v74
    ds_read_b128 v[24:27], v74 offset:1024
    s_mov_b64 exec, s[64:65]
    s_waitcnt lgkmcnt(1)
    buffer_store_dwordx4 v[20:23], v72, s[24:27], s42 offen sc1
    s_mov_b64 exec, vcc
    s_cbranch_execz TS2
    s_waitcnt lgkmcnt(0)
    buffer_store_dwordx4 v[24:27], v72, s[24:27], s42 offen offset:1024 sc1
TS2:
    s_mov_b64 exec, -1
K_END:
    s_endpgm
    .section .rodata,"a"
    .p2align 6
    .amdhsa_kernel standalone__spectral_conv_chebnet__graph_kernel
      .amdhsa_next_free_vgpr 128
      .amdhsa_next_free_sgpr 80
      .amdhsa_accum_offset 128
      .amdhsa_group_segment_fixed_size 0
      .amdhsa_kernarg_size 64
      .amdhsa_user_sgpr_count 2
      .amdhsa_user_sgpr_kernarg_segment_ptr 1
      .amdhsa_system_sgpr_workgroup_id_x 1
      .amdhsa_float_denorm_mode_32 3
      .amdhsa_float_denorm_mode_16_64 3
    .end_amdhsa_kernel
```
